```python
import torch

def _softmax(x, axis=-1):
    return torch.softmax(x, dim=axis)
def _gelu(x):
    return torch.nn.functional.gelu(x, approximate="tanh")
def _silu(x):
    return torch.nn.functional.silu(x)
def _sigmoid(x):
    return torch.sigmoid(x)
def _layernorm(x, axis=-1, eps=1e-5):
    m = x.mean(dim=axis, keepdim=True)
    v = x.var(dim=axis, keepdim=True, unbiased=False)
    return (x - m) / torch.sqrt(v + eps)
def _scatter_add(tgt, idx, src, axis=0):
    return tgt.clone().index_add_(axis, idx, src)
def _segment_sum(src, seg, n):
    out = torch.zeros((n,) + src.shape[1:], dtype=src.dtype)
    return out.index_add_(0, seg, src)
def _pad(x, pw):
    flat = tuple(v for pair in reversed(pw) for v in pair)
    return torch.nn.functional.pad(x, flat)

kernel_name = 'gated_mix__sliding_block_cached__glu_gated_reglu__decode'

def setup_inputs():

    _w = (lambda a: (lambda t: t.to(torch.bfloat16) if t.is_floating_point() else t)(torch.as_tensor(a)))
    def _A_setup():
        B, Sq, D = 4, 1, 512
        Hq, Hkv, Sk, Dh = 32, 8, 16384, 128
        assert Hq % Hkv == 0, (Hq, Hkv)
        return {
            "x": _w((lambda *s: torch.randn(*s, dtype=torch.bfloat16) * 0.05)(B, Sq, D)),
            "k_cache": _w((lambda *s: torch.randn(*s, dtype=torch.bfloat16) * 3.2)(B, Hkv, Sk, Dh)),
            "v_cache": _w((lambda *s: torch.randn(*s, dtype=torch.bfloat16) * 0.05)(B, Hkv, Sk, Dh)),
            "wq": _w((lambda *s: torch.randn(*s, dtype=torch.bfloat16) * 3.2)(D, Hq * Dh) * (D ** -0.5)),
            "wo": _w((lambda *s: torch.randn(*s, dtype=torch.bfloat16) * 0.05)(Hq * Dh, D) * ((Hq * Dh) ** -0.5)),
        }
    _A_in = _A_setup()

    def _B_setup():
        B, S, D, F = 4, 1, 512, 1792
        return {
            "x": _w((lambda *s: torch.randn(*s, dtype=torch.bfloat16) * 0.05)(B, S, D)),
            "W_gate": _w((lambda *s: torch.randn(*s, dtype=torch.bfloat16) * 0.2)(D, F) * (2.0 / D) ** 0.5),
            "W_up": _w((lambda *s: torch.randn(*s, dtype=torch.bfloat16) * 0.2)(D, F) * (2.0 / D) ** 0.5),
            "W_down": _w((lambda *s: torch.randn(*s, dtype=torch.bfloat16) * 0.2)(F, D) * (1.0 / F) ** 0.5),
        }
    _B_in = _B_setup()

    return {
        "A_x": _A_in["x"],
        "A_k_cache": _A_in["k_cache"],
        "A_v_cache": _A_in["v_cache"],
        "A_wq": _A_in["wq"],
        "A_wo": _A_in["wo"],
        "B_x": _B_in["x"],
        "B_W_gate": _B_in["W_gate"],
        "B_W_up": _B_in["W_up"],
        "B_W_down": _B_in["W_down"],
        "gate_w": _w((lambda *s: torch.randn(*s, dtype=torch.bfloat16) * 0.05)(512) * 16.0),
    }

def reference(A_x, A_k_cache, A_v_cache, A_wq, A_wo, B_x, B_W_gate, B_W_up, B_W_down, gate_w):
    def _A_ref(x, k_cache, v_cache, wq, wo):
        B, Sq, D = x.shape
        Hq, Dh = 32, 128
        Hkv, Sk = k_cache.shape[1], k_cache.shape[2]
        W = min(4096, max(256, Sk // 4))
        rep = Hq // Hkv
        q = (lambda x, *d: x.permute(*d))((x @ wq).reshape(B, Sq, Hq, Dh), 0, 2, 1, 3)
        k = (lambda x, n, axis: torch.repeat_interleave(x, n, dim=axis))(k_cache[:, :, Sk - W:, :], rep, axis=1)
        v = (lambda x, n, axis: torch.repeat_interleave(x, n, dim=axis))(v_cache[:, :, Sk - W:, :], rep, axis=1)
        scores = torch.einsum("bhqd,bhkd->bhqk", q, k) * (Dh ** -0.5)
        p = _softmax(scores, axis=-1)
        o = torch.einsum("bhqk,bhkd->bhqd", p, v)
        return (lambda x, *d: x.permute(*d))(o, 0, 2, 1, 3).reshape(B, Sq, Hq * Dh) @ wo

    def _B_ref(x, W_gate, W_up, W_down):
        gate = torch.einsum("bsd,df->bsf", x, W_gate)
        up = torch.einsum("bsd,df->bsf", x, W_up)
        gate = gate * (lambda x, dt: x.to(dt))(gate > 0, gate.dtype)
        h = gate * up
        return torch.einsum("bsf,fd->bsd", h, W_down)

    x = A_x
    g = _sigmoid((x * gate_w).sum(-1, keepdims=True))
    a = _A_ref(x, A_k_cache, A_v_cache, A_wq, A_wo)
    b = _B_ref(x, B_W_gate, B_W_up, B_W_down)
    return g * a + (1 - g) * b
```

```asm
; @launch kernel=k1_proj_kernel grid=(240,1,1) block=(256,1,1) lds=8192
; @launch kernel=k2_attn_kernel grid=(256,1,1) block=(1024,1,1) lds=34816
; @launch kernel=k3_oproj_kernel grid=(184,1,1) block=(256,1,1) lds=9216
; @launch kernel=k4_final_kernel grid=(8,1,1) block=(256,1,1) lds=0
.amdgcn_target "amdgcn-amd-amdhsa--gfx950"
.text
.globl k1_proj_kernel
.p2align 8
.type k1_proj_kernel,@function
k1_proj_kernel:
    s_cmp_ge_u32 s2, 240
    s_cbranch_scc1 K1_EXIT
    s_load_dwordx2 s[4:5], s[0:1], 0
    s_load_dwordx2 s[6:7], s[0:1], 24
    s_load_dwordx2 s[8:9], s[0:1], 48
    s_load_dwordx2 s[10:11], s[0:1], 56
    s_load_dwordx2 s[12:13], s[0:1], 96
    s_lshr_b32 s3, s2, 2
    s_and_b32 s14, s2, 3
    v_lshrrev_b32 v1, 6, v0
    v_and_b32 v2, 63, v0
    v_readfirstlane_b32 s15, v1
    v_and_b32 v3, 15, v2
    v_lshrrev_b32 v4, 4, v2
    s_mov_b32 s44, 0x05040100
    s_mov_b32 s45, 0x07060302
    s_waitcnt lgkmcnt(0)
    s_mov_b32 s16, s4
    s_and_b32 s17, s5, 0xffff
    s_mov_b32 s18, 4096
    s_mov_b32 s19, 0x00020000
    s_mov_b32 s20, s12
    s_and_b32 s21, s13, 0xffff
    s_mov_b32 s22, 1507328
    s_mov_b32 s23, 0x00020000
    s_cmp_ge_u32 s3, 32
    s_cbranch_scc1 K1_NOTQ
    s_mov_b32 s24, s6
    s_and_b32 s25, s7, 0xffff
    s_mov_b32 s26, 4194304
    s_mov_b32 s27, 0x00020000
    s_mov_b32 s36, 8192
    s_lshl_b32 s37, s3, 8
    s_mov_b32 s38, 0
    s_mov_b32 s39, 4096
    s_lshl_b32 s40, s3, 7
    s_branch K1_COMMON
K1_NOTQ:
    s_cmp_ge_u32 s3, 46
    s_cbranch_scc1 K1_UP
    s_mov_b32 s24, s8
    s_and_b32 s25, s9, 0xffff
    s_mov_b32 s26, 1835008
    s_mov_b32 s27, 0x00020000
    s_sub_u32 s3, s3, 32
    s_mov_b32 s38, 262144
    s_branch K1_FF
K1_UP:
    s_mov_b32 s24, s10
    s_and_b32 s25, s11, 0xffff
    s_mov_b32 s26, 1835008
    s_mov_b32 s27, 0x00020000
    s_sub_u32 s3, s3, 46
    s_mov_b32 s38, 393216
K1_FF:
    s_mov_b32 s36, 3584
    s_lshl_b32 s37, s3, 8
    s_mov_b32 s39, 1792
    s_lshl_b32 s40, s3, 7
K1_COMMON:
    s_lshl_b32 s41, s14, 7
    s_lshl_b32 s42, s15, 5
    s_add_u32 s41, s41, s42
    s_mul_i32 s28, s41, s36
    s_add_u32 s28, s28, s37
    s_add_u32 s29, s28, s36
    s_add_u32 s30, s29, s36
    s_add_u32 s31, s30, s36
    s_add_u32 s32, s31, s36
    s_add_u32 s33, s32, s36
    s_add_u32 s34, s33, s36
    s_add_u32 s35, s34, s36
    s_lshl_b32 s46, s36, 3
    v_mul_lo_u32 v5, v4, s46
    v_lshl_add_u32 v5, v3, 4, v5
    v_and_b32 v6, 3, v3
    v_lshlrev_b32 v6, 10, v6
    v_lshl_add_u32 v6, v4, 4, v6
    s_lshl_b32 s43, s41, 1
    buffer_load_dwordx4 v[8:11], v6, s[16:19], s43 offen
    buffer_load_dwordx4 v[16:19], v5, s[24:27], s28 offen sc1 nt
    buffer_load_dwordx4 v[20:23], v5, s[24:27], s29 offen sc1 nt
    buffer_load_dwordx4 v[24:27], v5, s[24:27], s30 offen sc1 nt
    buffer_load_dwordx4 v[28:31], v5, s[24:27], s31 offen sc1 nt
    buffer_load_dwordx4 v[32:35], v5, s[24:27], s32 offen sc1 nt
    buffer_load_dwordx4 v[36:39], v5, s[24:27], s33 offen sc1 nt
    buffer_load_dwordx4 v[40:43], v5, s[24:27], s34 offen sc1 nt
    buffer_load_dwordx4 v[44:47], v5, s[24:27], s35 offen sc1 nt
    s_lshl_b32 s47, s14, 2
    s_mul_i32 s47, s47, s39
    s_add_u32 s47, s47, s40
    s_lshl_b32 s47, s47, 2
    s_add_u32 s47, s47, s38
    s_lshl_b32 s48, s15, 11
    v_lshlrev_b32 v7, 7, v3
    v_add_u32 v7, s48, v7
    s_waitcnt vmcnt(0)
    v_perm_b32 v80, v20, v16, s44
    v_perm_b32 v81, v28, v24, s44
    v_perm_b32 v82, v36, v32, s44
    v_perm_b32 v83, v44, v40, s44
    v_perm_b32 v84, v20, v16, s45
    v_perm_b32 v85, v28, v24, s45
    v_perm_b32 v86, v36, v32, s45
    v_perm_b32 v87, v44, v40, s45
    v_mfma_f32_16x16x32_bf16 v[48:51], v[8:11], v[80:83], 0
    v_perm_b32 v88, v21, v17, s44
    v_perm_b32 v89, v29, v25, s44
    v_perm_b32 v90, v37, v33, s44
    v_perm_b32 v91, v45, v41, s44
    v_mfma_f32_16x16x32_bf16 v[52:55], v[8:11], v[84:87], 0
    v_perm_b32 v92, v21, v17, s45
    v_perm_b32 v93, v29, v25, s45
    v_perm_b32 v94, v37, v33, s45
    v_perm_b32 v95, v45, v41, s45
    v_mfma_f32_16x16x32_bf16 v[56:59], v[8:11], v[88:91], 0
    v_perm_b32 v80, v22, v18, s44
    v_perm_b32 v81, v30, v26, s44
    v_perm_b32 v82, v38, v34, s44
    v_perm_b32 v83, v46, v42, s44
    v_mfma_f32_16x16x32_bf16 v[60:63], v[8:11], v[92:95], 0
    v_perm_b32 v84, v22, v18, s45
    v_perm_b32 v85, v30, v26, s45
    v_perm_b32 v86, v38, v34, s45
    v_perm_b32 v87, v46, v42, s45
    v_mfma_f32_16x16x32_bf16 v[64:67], v[8:11], v[80:83], 0
    v_perm_b32 v88, v23, v19, s44
    v_perm_b32 v89, v31, v27, s44
    v_perm_b32 v90, v39, v35, s44
    v_perm_b32 v91, v47, v43, s44
    v_mfma_f32_16x16x32_bf16 v[68:71], v[8:11], v[84:87], 0
    v_perm_b32 v92, v23, v19, s45
    v_perm_b32 v93, v31, v27, s45
    v_perm_b32 v94, v39, v35, s45
    v_perm_b32 v95, v47, v43, s45
    v_mfma_f32_16x16x32_bf16 v[72:75], v[8:11], v[88:91], 0
    s_nop 1
    v_mfma_f32_16x16x32_bf16 v[76:79], v[8:11], v[92:95], 0
    s_nop 7
    s_mov_b64 exec, 0xffff
    ds_write_b128 v7, v[48:51] offset:0
    ds_write_b128 v7, v[52:55] offset:16
    ds_write_b128 v7, v[56:59] offset:32
    ds_write_b128 v7, v[60:63] offset:48
    ds_write_b128 v7, v[64:67] offset:64
    ds_write_b128 v7, v[68:71] offset:80
    ds_write_b128 v7, v[72:75] offset:96
    ds_write_b128 v7, v[76:79] offset:112
    s_mov_b64 exec, -1
    s_waitcnt lgkmcnt(0)
    s_barrier
    v_lshlrev_b32 v96, 2, v0
    ds_read_b32 v98, v96 offset:0
    ds_read_b32 v102, v96 offset:1024
    ds_read_b32 v99, v96 offset:2048
    ds_read_b32 v103, v96 offset:3072
    ds_read_b32 v100, v96 offset:4096
    ds_read_b32 v104, v96 offset:5120
    ds_read_b32 v101, v96 offset:6144
    ds_read_b32 v105, v96 offset:7168
    v_and_b32 v106, 3, v0
    v_mul_lo_u32 v106, v106, s39
    v_lshrrev_b32 v107, 5, v0
    v_lshlrev_b32 v107, 3, v107
    v_bfe_u32 v108, v0, 2, 3
    v_add3_u32 v106, v106, v107, v108
    v_lshlrev_b32 v106, 2, v106
    s_waitcnt lgkmcnt(0)
    v_add_f32 v98, v98, v99
    v_add_f32 v100, v100, v101
    v_add_f32 v102, v102, v103
    v_add_f32 v104, v104, v105
    v_add_f32 v98, v98, v100
    v_add_f32 v102, v102, v104
    buffer_store_dword v98, v106, s[20:23], s47 offen
    buffer_store_dword v102, v106, s[20:23], s47 offen offset:256
K1_END:
K1_EXIT:
    s_endpgm
.globl k2_attn_kernel
.p2align 8
.type k2_attn_kernel,@function
k2_attn_kernel:
    s_cmp_ge_u32 s2, 256
    s_cbranch_scc1 K2_EXIT
    s_load_dwordx4 s[4:7], s[0:1], 8
    s_load_dwordx2 s[8:9], s[0:1], 96
    s_lshr_b32 s3, s2, 3
    s_and_b32 s10, s2, 7
    v_lshrrev_b32 v1, 6, v0
    v_and_b32 v2, 63, v0
    v_readfirstlane_b32 s11, v1
    v_and_b32 v3, 15, v2
    v_lshrrev_b32 v4, 4, v2
    s_mov_b32 s44, 0x05040100
    s_mov_b32 s45, 0x07060302
    s_mov_b32 s46, 0x3e0293ee
    s_waitcnt lgkmcnt(0)
    s_mov_b32 s12, s4
    s_and_b32 s13, s5, 0xffff
    s_mov_b32 s14, 134217728
    s_mov_b32 s15, 0x00020000
    s_mov_b32 s16, s6
    s_and_b32 s17, s7, 0xffff
    s_mov_b32 s18, 134217728
    s_mov_b32 s19, 0x00020000
    s_mov_b32 s20, s8
    s_and_b32 s21, s9, 0xffff
    s_mov_b32 s22, 1507328
    s_mov_b32 s23, 0x00020000
    s_lshr_b32 s24, s3, 3
    s_and_b32 s25, s3, 7
    s_lshl_b32 s26, s24, 14
    s_lshl_b32 s27, s25, 11
    s_add_u32 s26, s26, s27
    s_add_u32 s26, s26, 0
    v_and_b32 v5, 511, v0
    v_lshlrev_b32 v5, 2, v5
    buffer_load_dword v8, v5, s[20:23], s26 offen
    s_add_u32 s26, s26, 65536
    buffer_load_dword v9, v5, s[20:23], s26 offen
    s_add_u32 s26, s26, 65536
    buffer_load_dword v10, v5, s[20:23], s26 offen
    s_add_u32 s26, s26, 65536
    buffer_load_dword v11, v5, s[20:23], s26 offen
    s_lshl_b32 s28, s3, 22
    s_lshl_b32 s29, s10, 17
    s_add_u32 s28, s28, s29
    s_lshl_b32 s29, s11, 13
    s_add_u32 s28, s28, s29
    s_add_u32 s28, s28, 3145728
    s_add_u32 s29, s28, 4096
    v_lshlrev_b32 v6, 8, v3
    v_lshl_add_u32 v6, v4, 4, v6
    v_lshlrev_b32 v7, 10, v4
    v_lshl_add_u32 v7, v3, 4, v7
    buffer_load_dwordx4 v[16:19], v6, s[12:15], s28 offen offset:0 sc1 nt
    buffer_load_dwordx4 v[20:23], v6, s[12:15], s28 offen offset:64 sc1 nt
    buffer_load_dwordx4 v[24:27], v6, s[12:15], s28 offen offset:128 sc1 nt
    buffer_load_dwordx4 v[28:31], v6, s[12:15], s28 offen offset:192 sc1 nt
    buffer_load_dwordx4 v[32:35], v6, s[12:15], s29 offen offset:0 sc1 nt
    buffer_load_dwordx4 v[36:39], v6, s[12:15], s29 offen offset:64 sc1 nt
    buffer_load_dwordx4 v[40:43], v6, s[12:15], s29 offen offset:128 sc1 nt
    buffer_load_dwordx4 v[44:47], v6, s[12:15], s29 offen offset:192 sc1 nt
    buffer_load_dwordx4 v[48:51], v7, s[16:19], s28 offen offset:0 sc1 nt
    buffer_load_dwordx4 v[52:55], v7, s[16:19], s28 offen offset:256 sc1 nt
    buffer_load_dwordx4 v[56:59], v7, s[16:19], s28 offen offset:512 sc1 nt
    buffer_load_dwordx4 v[60:63], v7, s[16:19], s28 offen offset:768 sc1 nt
    buffer_load_dwordx4 v[64:67], v7, s[16:19], s29 offen offset:0 sc1 nt
    buffer_load_dwordx4 v[68:71], v7, s[16:19], s29 offen offset:256 sc1 nt
    buffer_load_dwordx4 v[72:75], v7, s[16:19], s29 offen offset:512 sc1 nt
    buffer_load_dwordx4 v[76:79], v7, s[16:19], s29 offen offset:768 sc1 nt
    s_waitcnt vmcnt(16)
    v_add_f32 v8, v8, v9
    v_add_f32 v10, v10, v11
    v_add_f32 v8, v8, v10
    v_cvt_pk_bf16_f32 v8, v8, v8
    v_lshrrev_b32 v5, 1, v5
    ds_write_b16 v5, v8 offset:0
    s_waitcnt lgkmcnt(0)
    s_barrier
    v_and_b32 v5, 3, v3
    v_lshlrev_b32 v5, 8, v5
    v_lshl_add_u32 v5, v4, 4, v5
    ds_read_b128 v[80:83], v5 offset:0
    ds_read_b128 v[84:87], v5 offset:64
    ds_read_b128 v[88:91], v5 offset:128
    ds_read_b128 v[92:95], v5 offset:192
    s_waitcnt vmcnt(8) lgkmcnt(0)
    v_mfma_f32_16x16x32_bf16 v[96:99], v[16:19], v[80:83], 0
    v_mfma_f32_16x16x32_bf16 v[96:99], v[20:23], v[84:87], v[96:99]
    v_mfma_f32_16x16x32_bf16 v[96:99], v[24:27], v[88:91], v[96:99]
    v_mfma_f32_16x16x32_bf16 v[96:99], v[28:31], v[92:95], v[96:99]
    v_mfma_f32_16x16x32_bf16 v[100:103], v[32:35], v[80:83], 0
    v_mfma_f32_16x16x32_bf16 v[100:103], v[36:39], v[84:87], v[100:103]
    v_mfma_f32_16x16x32_bf16 v[100:103], v[40:43], v[88:91], v[100:103]
    v_mfma_f32_16x16x32_bf16 v[100:103], v[44:47], v[92:95], v[100:103]
    s_nop 7
    v_max3_f32 v108, v96, v97, v98
    v_max3_f32 v108, v108, v99, v100
    v_max3_f32 v108, v108, v101, v102
    v_max_f32 v108, v108, v103
    v_mov_b32 v109, v108
    s_nop 1
    v_permlane16_swap_b32 v108, v109
    s_nop 1
    v_max_f32 v108, v108, v109
    v_mov_b32 v109, v108
    s_nop 1
    v_permlane32_swap_b32 v108, v109
    s_nop 1
    v_max_f32 v108, v108, v109
    v_mul_f32 v110, s46, v108
    v_sub_f32 v111, 0, v110
    v_fma_f32 v96, v96, s46, v111
    v_fma_f32 v97, v97, s46, v111
    v_fma_f32 v98, v98, s46, v111
    v_fma_f32 v99, v99, s46, v111
    v_fma_f32 v100, v100, s46, v111
    v_fma_f32 v101, v101, s46, v111
    v_fma_f32 v102, v102, s46, v111
    v_fma_f32 v103, v103, s46, v111
    v_exp_f32 v96, v96
    v_exp_f32 v97, v97
    v_exp_f32 v98, v98
    v_exp_f32 v99, v99
    v_exp_f32 v100, v100
    v_exp_f32 v101, v101
    v_exp_f32 v102, v102
    v_exp_f32 v103, v103
    s_nop 0
    v_add_f32 v112, v96, v97
    v_add_f32 v113, v98, v99
    v_add_f32 v114, v100, v101
    v_add_f32 v115, v102, v103
    v_add_f32 v112, v112, v113
    v_add_f32 v114, v114, v115
    v_add_f32 v112, v112, v114
    v_mov_b32 v113, v112
    s_nop 1
    v_permlane16_swap_b32 v112, v113
    s_nop 1
    v_add_f32 v112, v112, v113
    v_mov_b32 v113, v112
    s_nop 1
    v_permlane32_swap_b32 v112, v113
    s_nop 1
    v_add_f32 v112, v112, v113
    v_cvt_pk_bf16_f32 v104, v96, v97
    v_cvt_pk_bf16_f32 v105, v98, v99
    v_cvt_pk_bf16_f32 v106, v100, v101
    v_cvt_pk_bf16_f32 v107, v102, v103
    s_waitcnt vmcnt(0)
    v_perm_b32 v80, v52, v48, s44
    v_perm_b32 v81, v60, v56, s44
    v_perm_b32 v82, v68, v64, s44
    v_perm_b32 v83, v76, v72, s44
    v_perm_b32 v84, v52, v48, s45
    v_perm_b32 v85, v60, v56, s45
    v_perm_b32 v86, v68, v64, s45
    v_perm_b32 v87, v76, v72, s45
    v_mfma_f32_16x16x32_bf16 v[16:19], v[104:107], v[80:83], 0
    v_perm_b32 v88, v53, v49, s44
    v_perm_b32 v89, v61, v57, s44
    v_perm_b32 v90, v69, v65, s44
    v_perm_b32 v91, v77, v73, s44
    v_mfma_f32_16x16x32_bf16 v[20:23], v[104:107], v[84:87], 0
    v_perm_b32 v92, v53, v49, s45
    v_perm_b32 v93, v61, v57, s45
    v_perm_b32 v94, v69, v65, s45
    v_perm_b32 v95, v77, v73, s45
    v_mfma_f32_16x16x32_bf16 v[24:27], v[104:107], v[88:91], 0
    v_perm_b32 v80, v54, v50, s44
    v_perm_b32 v81, v62, v58, s44
    v_perm_b32 v82, v70, v66, s44
    v_perm_b32 v83, v78, v74, s44
    v_mfma_f32_16x16x32_bf16 v[28:31], v[104:107], v[92:95], 0
    v_perm_b32 v84, v54, v50, s45
    v_perm_b32 v85, v62, v58, s45
    v_perm_b32 v86, v70, v66, s45
    v_perm_b32 v87, v78, v74, s45
    v_mfma_f32_16x16x32_bf16 v[32:35], v[104:107], v[80:83], 0
    v_perm_b32 v88, v55, v51, s44
    v_perm_b32 v89, v63, v59, s44
    v_perm_b32 v90, v71, v67, s44
    v_perm_b32 v91, v79, v75, s44
    v_mfma_f32_16x16x32_bf16 v[36:39], v[104:107], v[84:87], 0
    v_perm_b32 v92, v55, v51, s45
    v_perm_b32 v93, v63, v59, s45
    v_perm_b32 v94, v71, v67, s45
    v_perm_b32 v95, v79, v75, s45
    v_mfma_f32_16x16x32_bf16 v[40:43], v[104:107], v[88:91], 0
    s_nop 1
    v_mfma_f32_16x16x32_bf16 v[44:47], v[104:107], v[92:95], 0
    s_nop 7
    s_lshl_b32 s30, s11, 11
    v_lshlrev_b32 v5, 7, v3
    v_add_u32 v5, s30, v5
    s_mov_b64 exec, 0xffff
    ds_write_b128 v5, v[16:19] offset:2048
    ds_write_b128 v5, v[20:23] offset:2064
    ds_write_b128 v5, v[24:27] offset:2080
    ds_write_b128 v5, v[28:31] offset:2096
    ds_write_b128 v5, v[32:35] offset:2112
    ds_write_b128 v5, v[36:39] offset:2128
    ds_write_b128 v5, v[40:43] offset:2144
    ds_write_b128 v5, v[44:47] offset:2160
    s_mov_b64 exec, 0xf
    s_lshl_b32 s30, s11, 5
    v_lshlrev_b32 v5, 3, v3
    v_add_u32 v5, s30, v5
    v_mov_b32 v111, v112
    ds_write_b64 v5, v[110:111] offset:1024
    s_mov_b64 exec, -1
    s_waitcnt lgkmcnt(0)
    s_barrier
    s_cmp_ge_u32 s11, 8
    s_cbranch_scc1 K2_END
    v_and_b32 v5, 3, v0
    v_lshlrev_b32 v5, 3, v5
    v_lshlrev_b32 v6, 2, v0
    ds_read_b64 v[16:17], v5 offset:1024
    ds_read_b64 v[18:19], v5 offset:1056
    ds_read_b64 v[20:21], v5 offset:1088
    ds_read_b64 v[22:23], v5 offset:1120
    ds_read_b64 v[24:25], v5 offset:1152
    ds_read_b64 v[26:27], v5 offset:1184
    ds_read_b64 v[28:29], v5 offset:1216
    ds_read_b64 v[30:31], v5 offset:1248
    ds_read_b64 v[32:33], v5 offset:1280
    ds_read_b64 v[34:35], v5 offset:1312
    ds_read_b64 v[36:37], v5 offset:1344
    ds_read_b64 v[38:39], v5 offset:1376
    ds_read_b64 v[40:41], v5 offset:1408
    ds_read_b64 v[42:43], v5 offset:1440
    ds_read_b64 v[44:45], v5 offset:1472
    ds_read_b64 v[46:47], v5 offset:1504
    ds_read_b32 v48, v6 offset:2048
    ds_read_b32 v49, v6 offset:4096
    ds_read_b32 v50, v6 offset:6144
    ds_read_b32 v51, v6 offset:8192
    ds_read_b32 v52, v6 offset:10240
    ds_read_b32 v53, v6 offset:12288
    ds_read_b32 v54, v6 offset:14336
    ds_read_b32 v55, v6 offset:16384
    ds_read_b32 v56, v6 offset:18432
    ds_read_b32 v57, v6 offset:20480
    ds_read_b32 v58, v6 offset:22528
    ds_read_b32 v59, v6 offset:24576
    ds_read_b32 v60, v6 offset:26624
    ds_read_b32 v61, v6 offset:28672
    ds_read_b32 v62, v6 offset:30720
    ds_read_b32 v63, v6 offset:32768
    s_waitcnt lgkmcnt(0)
    v_max3_f32 v8, v16, v18, v20
    v_max3_f32 v8, v8, v22, v24
    v_max3_f32 v8, v8, v26, v28
    v_max3_f32 v8, v8, v30, v32
    v_max3_f32 v8, v8, v34, v36
    v_max3_f32 v8, v8, v38, v40
    v_max3_f32 v8, v8, v42, v44
    v_max_f32 v8, v8, v46
    v_sub_f32 v16, v16, v8
    v_sub_f32 v18, v18, v8
    v_sub_f32 v20, v20, v8
    v_sub_f32 v22, v22, v8
    v_sub_f32 v24, v24, v8
    v_sub_f32 v26, v26, v8
    v_sub_f32 v28, v28, v8
    v_sub_f32 v30, v30, v8
    v_sub_f32 v32, v32, v8
    v_sub_f32 v34, v34, v8
    v_sub_f32 v36, v36, v8
    v_sub_f32 v38, v38, v8
    v_sub_f32 v40, v40, v8
    v_sub_f32 v42, v42, v8
    v_sub_f32 v44, v44, v8
    v_sub_f32 v46, v46, v8
    v_exp_f32 v16, v16
    v_exp_f32 v18, v18
    v_exp_f32 v20, v20
    v_exp_f32 v22, v22
    v_exp_f32 v24, v24
    v_exp_f32 v26, v26
    v_exp_f32 v28, v28
    v_exp_f32 v30, v30
    v_exp_f32 v32, v32
    v_exp_f32 v34, v34
    v_exp_f32 v36, v36
    v_exp_f32 v38, v38
    v_exp_f32 v40, v40
    v_exp_f32 v42, v42
    v_exp_f32 v44, v44
    v_exp_f32 v46, v46
    v_mov_b32 v9, 0
    v_mov_b32 v10, 0
    v_fmac_f32 v9, v16, v17
    v_fmac_f32 v10, v16, v48
    v_fmac_f32 v9, v18, v19
    v_fmac_f32 v10, v18, v49
    v_fmac_f32 v9, v20, v21
    v_fmac_f32 v10, v20, v50
    v_fmac_f32 v9, v22, v23
    v_fmac_f32 v10, v22, v51
    v_fmac_f32 v9, v24, v25
    v_fmac_f32 v10, v24, v52
    v_fmac_f32 v9, v26, v27
    v_fmac_f32 v10, v26, v53
    v_fmac_f32 v9, v28, v29
    v_fmac_f32 v10, v28, v54
    v_fmac_f32 v9, v30, v31
    v_fmac_f32 v10, v30, v55
    v_fmac_f32 v9, v32, v33
    v_fmac_f32 v10, v32, v56
    v_fmac_f32 v9, v34, v35
    v_fmac_f32 v10, v34, v57
    v_fmac_f32 v9, v36, v37
    v_fmac_f32 v10, v36, v58
    v_fmac_f32 v9, v38, v39
    v_fmac_f32 v10, v38, v59
    v_fmac_f32 v9, v40, v41
    v_fmac_f32 v10, v40, v60
    v_fmac_f32 v9, v42, v43
    v_fmac_f32 v10, v42, v61
    v_fmac_f32 v9, v44, v45
    v_fmac_f32 v10, v44, v62
    v_fmac_f32 v9, v46, v47
    v_fmac_f32 v10, v46, v63
    s_lshl_b32 s30, s24, 5
    s_lshl_b32 s31, s25, 2
    s_add_u32 s30, s30, s31
    s_lshl_b32 s30, s30, 3
    s_add_u32 s30, s30, s10
    s_lshl_b32 s31, s30, 9
    s_add_u32 s31, s31, 524288
    v_and_b32 v11, 3, v0
    v_lshlrev_b32 v12, 12, v11
    v_lshrrev_b32 v13, 5, v0
    v_lshlrev_b32 v13, 5, v13
    v_bfe_u32 v14, v0, 2, 3
    v_lshl_add_u32 v13, v14, 2, v13
    v_add_u32 v12, v12, v13
    buffer_store_dword v10, v12, s[20:23], s31 offen
    s_cmp_lg_u32 s11, 0
    s_cbranch_scc1 K2_END
    s_mov_b64 exec, 0xf
    s_lshl_b32 s31, s30, 3
    s_add_u32 s31, s31, 1048576
    v_lshlrev_b32 v12, 6, v11
    v_mov_b32 v7, v9
    v_mov_b32 v6, v8
    buffer_store_dwordx2 v[6:7], v12, s[20:23], s31 offen
K2_END:
K2_EXIT:
    s_endpgm
.globl k3_oproj_kernel
.p2align 8
.type k3_oproj_kernel,@function
k3_oproj_kernel:
    s_cmp_ge_u32 s2, 184
    s_cbranch_scc1 K3_EXIT
    s_load_dwordx2 s[4:5], s[0:1], 32
    s_load_dwordx2 s[6:7], s[0:1], 64
    s_load_dwordx2 s[8:9], s[0:1], 96
    s_lshr_b32 s3, s2, 2
    s_and_b32 s10, s2, 3
    v_lshrrev_b32 v1, 6, v0
    v_and_b32 v2, 63, v0
    v_readfirstlane_b32 s11, v1
    v_and_b32 v3, 15, v2
    v_lshrrev_b32 v4, 4, v2
    s_mov_b32 s44, 0x05040100
    s_mov_b32 s45, 0x07060302
    v_lshlrev_b32 v5, 13, v4
    v_lshl_add_u32 v5, v3, 4, v5
    s_lshl_b32 s24, s11, 15
    s_lshl_b32 s25, s10, 8
    s_add_u32 s24, s24, s25
    s_waitcnt lgkmcnt(0)
    s_mov_b32 s20, s8
    s_and_b32 s21, s9, 0xffff
    s_mov_b32 s22, 1507328
    s_mov_b32 s23, 0x00020000
    s_cmp_ge_u32 s3, 32
    s_cbranch_scc1 K3_FFN
    s_mov_b32 s12, s4
    s_and_b32 s13, s5, 0xffff
    s_mov_b32 s14, 4194304
    s_mov_b32 s15, 0x00020000
    s_lshl_b32 s25, s3, 17
    s_add_u32 s24, s24, s25
    s_add_u32 s25, s24, 4096
    buffer_load_dwordx4 v[16:19], v5, s[12:15], s24 offen offset:0 sc1 nt
    buffer_load_dwordx4 v[20:23], v5, s[12:15], s24 offen offset:1024 sc1 nt
    buffer_load_dwordx4 v[24:27], v5, s[12:15], s24 offen offset:2048 sc1 nt
    buffer_load_dwordx4 v[28:31], v5, s[12:15], s24 offen offset:3072 sc1 nt
    buffer_load_dwordx4 v[32:35], v5, s[12:15], s25 offen offset:0 sc1 nt
    buffer_load_dwordx4 v[36:39], v5, s[12:15], s25 offen offset:1024 sc1 nt
    buffer_load_dwordx4 v[40:43], v5, s[12:15], s25 offen offset:2048 sc1 nt
    buffer_load_dwordx4 v[44:47], v5, s[12:15], s25 offen offset:3072 sc1 nt
    v_lshrrev_b32 v6, 7, v0
    v_and_b32 v7, 127, v0
    v_lshlrev_b32 v8, 17, v6
    v_lshl_add_u32 v8, v7, 2, v8
    v_add_u32 v9, 0x40000, v8
    v_lshlrev_b32 v10, 11, v6
    v_add_u32 v11, 0x1000, v10
    s_lshl_b32 s26, s3, 12
    s_add_u32 s26, s26, 524288
    s_lshl_b32 s27, s3, 6
    s_add_u32 s27, s27, 1048576
    buffer_load_dword v96, v8, s[20:23], s26 offen offset:0
    buffer_load_dword v104, v9, s[20:23], s26 offen offset:0
    buffer_load_dwordx2 v[112:113], v10, s[20:23], s27 offen offset:0
    buffer_load_dwordx2 v[128:129], v11, s[20:23], s27 offen offset:0
    buffer_load_dword v97, v8, s[20:23], s26 offen offset:512
    buffer_load_dword v105, v9, s[20:23], s26 offen offset:512
    buffer_load_dwordx2 v[114:115], v10, s[20:23], s27 offen offset:8
    buffer_load_dwordx2 v[130:131], v11, s[20:23], s27 offen offset:8
    buffer_load_dword v98, v8, s[20:23], s26 offen offset:1024
    buffer_load_dword v106, v9, s[20:23], s26 offen offset:1024
    buffer_load_dwordx2 v[116:117], v10, s[20:23], s27 offen offset:16
    buffer_load_dwordx2 v[132:133], v11, s[20:23], s27 offen offset:16
    buffer_load_dword v99, v8, s[20:23], s26 offen offset:1536
    buffer_load_dword v107, v9, s[20:23], s26 offen offset:1536
    buffer_load_dwordx2 v[118:119], v10, s[20:23], s27 offen offset:24
    buffer_load_dwordx2 v[134:135], v11, s[20:23], s27 offen offset:24
    buffer_load_dword v100, v8, s[20:23], s26 offen offset:2048
    buffer_load_dword v108, v9, s[20:23], s26 offen offset:2048
    buffer_load_dwordx2 v[120:121], v10, s[20:23], s27 offen offset:32
    buffer_load_dwordx2 v[136:137], v11, s[20:23], s27 offen offset:32
    buffer_load_dword v101, v8, s[20:23], s26 offen offset:2560
    buffer_load_dword v109, v9, s[20:23], s26 offen offset:2560
    buffer_load_dwordx2 v[122:123], v10, s[20:23], s27 offen offset:40
    buffer_load_dwordx2 v[138:139], v11, s[20:23], s27 offen offset:40
    buffer_load_dword v102, v8, s[20:23], s26 offen offset:3072
    buffer_load_dword v110, v9, s[20:23], s26 offen offset:3072
    buffer_load_dwordx2 v[124:125], v10, s[20:23], s27 offen offset:48
    buffer_load_dwordx2 v[140:141], v11, s[20:23], s27 offen offset:48
    buffer_load_dword v103, v8, s[20:23], s26 offen offset:3584
    buffer_load_dword v111, v9, s[20:23], s26 offen offset:3584
    buffer_load_dwordx2 v[126:127], v10, s[20:23], s27 offen offset:56
    buffer_load_dwordx2 v[142:143], v11, s[20:23], s27 offen offset:56
    s_waitcnt vmcnt(0)
    v_max3_f32 v12, v112, v114, v116
    v_max3_f32 v12, v12, v118, v120
    v_max3_f32 v12, v12, v122, v124
    v_max_f32 v12, v12, v126
    v_sub_f32 v112, v112, v12
    v_sub_f32 v114, v114, v12
    v_sub_f32 v116, v116, v12
    v_sub_f32 v118, v118, v12
    v_sub_f32 v120, v120, v12
    v_sub_f32 v122, v122, v12
    v_sub_f32 v124, v124, v12
    v_sub_f32 v126, v126, v12
    v_exp_f32 v112, v112
    v_exp_f32 v114, v114
    v_exp_f32 v116, v116
    v_exp_f32 v118, v118
    v_exp_f32 v120, v120
    v_exp_f32 v122, v122
    v_exp_f32 v124, v124
    v_exp_f32 v126, v126
    v_mov_b32 v13, 0
    v_mov_b32 v14, 0
    v_fmac_f32 v13, v112, v113
    v_fmac_f32 v14, v112, v96
    v_fmac_f32 v13, v114, v115
    v_fmac_f32 v14, v114, v97
    v_fmac_f32 v13, v116, v117
    v_fmac_f32 v14, v116, v98
    v_fmac_f32 v13, v118, v119
    v_fmac_f32 v14, v118, v99
    v_fmac_f32 v13, v120, v121
    v_fmac_f32 v14, v120, v100
    v_fmac_f32 v13, v122, v123
    v_fmac_f32 v14, v122, v101
    v_fmac_f32 v13, v124, v125
    v_fmac_f32 v14, v124, v102
    v_fmac_f32 v13, v126, v127
    v_fmac_f32 v14, v126, v103
    v_rcp_f32 v13, v13
    s_nop 0
    v_mul_f32 v80, v14, v13
    v_max3_f32 v12, v128, v130, v132
    v_max3_f32 v12, v12, v134, v136
    v_max3_f32 v12, v12, v138, v140
    v_max_f32 v12, v12, v142
    v_sub_f32 v128, v128, v12
    v_sub_f32 v130, v130, v12
    v_sub_f32 v132, v132, v12
    v_sub_f32 v134, v134, v12
    v_sub_f32 v136, v136, v12
    v_sub_f32 v138, v138, v12
    v_sub_f32 v140, v140, v12
    v_sub_f32 v142, v142, v12
    v_exp_f32 v128, v128
    v_exp_f32 v130, v130
    v_exp_f32 v132, v132
    v_exp_f32 v134, v134
    v_exp_f32 v136, v136
    v_exp_f32 v138, v138
    v_exp_f32 v140, v140
    v_exp_f32 v142, v142
    v_mov_b32 v13, 0
    v_mov_b32 v14, 0
    v_fmac_f32 v13, v128, v129
    v_fmac_f32 v14, v128, v104
    v_fmac_f32 v13, v130, v131
    v_fmac_f32 v14, v130, v105
    v_fmac_f32 v13, v132, v133
    v_fmac_f32 v14, v132, v106
    v_fmac_f32 v13, v134, v135
    v_fmac_f32 v14, v134, v107
    v_fmac_f32 v13, v136, v137
    v_fmac_f32 v14, v136, v108
    v_fmac_f32 v13, v138, v139
    v_fmac_f32 v14, v138, v109
    v_fmac_f32 v13, v140, v141
    v_fmac_f32 v14, v140, v110
    v_fmac_f32 v13, v142, v143
    v_fmac_f32 v14, v142, v111
    v_rcp_f32 v13, v13
    s_nop 0
    v_mul_f32 v81, v14, v13
    s_branch K3_ACT
K3_FFN:
    s_mov_b32 s12, s6
    s_and_b32 s13, s7, 0xffff
    s_mov_b32 s14, 1835008
    s_mov_b32 s15, 0x00020000
    s_sub_u32 s3, s3, 32
    s_lshl_b32 s25, s3, 17
    s_add_u32 s24, s24, s25
    s_add_u32 s25, s24, 4096
    buffer_load_dwordx4 v[16:19], v5, s[12:15], s24 offen offset:0 sc1 nt
    buffer_load_dwordx4 v[20:23], v5, s[12:15], s24 offen offset:1024 sc1 nt
    buffer_load_dwordx4 v[24:27], v5, s[12:15], s24 offen offset:2048 sc1 nt
    buffer_load_dwordx4 v[28:31], v5, s[12:15], s24 offen offset:3072 sc1 nt
    buffer_load_dwordx4 v[32:35], v5, s[12:15], s25 offen offset:0 sc1 nt
    buffer_load_dwordx4 v[36:39], v5, s[12:15], s25 offen offset:1024 sc1 nt
    buffer_load_dwordx4 v[40:43], v5, s[12:15], s25 offen offset:2048 sc1 nt
    buffer_load_dwordx4 v[44:47], v5, s[12:15], s25 offen offset:3072 sc1 nt
    v_lshrrev_b32 v6, 7, v0
    v_and_b32 v7, 127, v0
    v_mov_b32 v8, 7168
    v_mul_lo_u32 v8, v6, v8
    v_lshl_add_u32 v8, v7, 2, v8
    v_add_u32 v9, 14336, v8
    s_lshl_b32 s26, s3, 9
    s_add_u32 s27, s26, 393216
    s_add_u32 s26, s26, 262144
    buffer_load_dword v96, v8, s[20:23], s26 offen
    buffer_load_dword v100, v9, s[20:23], s26 offen
    buffer_load_dword v104, v8, s[20:23], s27 offen
    buffer_load_dword v108, v9, s[20:23], s27 offen
    s_add_u32 s26, s26, 28672
    s_add_u32 s27, s27, 28672
    buffer_load_dword v97, v8, s[20:23], s26 offen
    buffer_load_dword v101, v9, s[20:23], s26 offen
    buffer_load_dword v105, v8, s[20:23], s27 offen
    buffer_load_dword v109, v9, s[20:23], s27 offen
    s_add_u32 s26, s26, 28672
    s_add_u32 s27, s27, 28672
    buffer_load_dword v98, v8, s[20:23], s26 offen
    buffer_load_dword v102, v9, s[20:23], s26 offen
    buffer_load_dword v106, v8, s[20:23], s27 offen
    buffer_load_dword v110, v9, s[20:23], s27 offen
    s_add_u32 s26, s26, 28672
    s_add_u32 s27, s27, 28672
    buffer_load_dword v99, v8, s[20:23], s26 offen
    buffer_load_dword v103, v9, s[20:23], s26 offen
    buffer_load_dword v107, v8, s[20:23], s27 offen
    buffer_load_dword v111, v9, s[20:23], s27 offen
    s_waitcnt vmcnt(0)
    v_add_f32 v96, v96, v97
    v_add_f32 v98, v98, v99
    v_add_f32 v96, v96, v98
    v_add_f32 v104, v104, v105
    v_add_f32 v106, v106, v107
    v_add_f32 v104, v104, v106
    v_cvt_pk_bf16_f32 v12, v96, v104
    v_lshlrev_b32 v13, 16, v12
    v_and_b32 v14, 0xffff0000, v12
    v_max_f32 v13, 0, v13
    v_mul_f32 v80, v13, v14
    v_add_f32 v100, v100, v101
    v_add_f32 v102, v102, v103
    v_add_f32 v100, v100, v102
    v_add_f32 v108, v108, v109
    v_add_f32 v110, v110, v111
    v_add_f32 v108, v108, v110
    v_cvt_pk_bf16_f32 v12, v100, v108
    v_lshlrev_b32 v13, 16, v12
    v_and_b32 v14, 0xffff0000, v12
    v_max_f32 v13, 0, v13
    v_mul_f32 v81, v13, v14
K3_ACT:
    v_cvt_pk_bf16_f32 v82, v80, v81
    v_lshlrev_b32 v12, 8, v6
    v_lshl_add_u32 v12, v7, 1, v12
    ds_write_b16 v12, v82 offset:8192
    ds_write_b16_d16_hi v12, v82 offset:8704
    s_waitcnt lgkmcnt(0)
    s_barrier
    v_and_b32 v12, 3, v3
    v_lshlrev_b32 v12, 8, v12
    v_lshl_add_u32 v12, v4, 4, v12
    s_lshl_b32 s28, s11, 6
    v_add_u32 v12, s28, v12
    ds_read_b128 v[8:11], v12 offset:8192
    s_lshr_b32 s3, s2, 2
    s_lshl_b32 s47, s3, 13
    s_lshl_b32 s28, s10, 9
    s_add_u32 s47, s47, s28
    s_add_u32 s47, s47, 1114112
    s_mov_b32 s39, 512
    s_lshl_b32 s48, s11, 11
    v_lshlrev_b32 v7, 7, v3
    v_add_u32 v7, s48, v7
    s_waitcnt lgkmcnt(0)
    v_perm_b32 v80, v20, v16, s44
    v_perm_b32 v81, v28, v24, s44
    v_perm_b32 v82, v36, v32, s44
    v_perm_b32 v83, v44, v40, s44
    v_perm_b32 v84, v20, v16, s45
    v_perm_b32 v85, v28, v24, s45
    v_perm_b32 v86, v36, v32, s45
    v_perm_b32 v87, v44, v40, s45
    v_mfma_f32_16x16x32_bf16 v[48:51], v[8:11], v[80:83], 0
    v_perm_b32 v88, v21, v17, s44
    v_perm_b32 v89, v29, v25, s44
    v_perm_b32 v90, v37, v33, s44
    v_perm_b32 v91, v45, v41, s44
    v_mfma_f32_16x16x32_bf16 v[52:55], v[8:11], v[84:87], 0
    v_perm_b32 v92, v21, v17, s45
    v_perm_b32 v93, v29, v25, s45
    v_perm_b32 v94, v37, v33, s45
    v_perm_b32 v95, v45, v41, s45
    v_mfma_f32_16x16x32_bf16 v[56:59], v[8:11], v[88:91], 0
    v_perm_b32 v80, v22, v18, s44
    v_perm_b32 v81, v30, v26, s44
    v_perm_b32 v82, v38, v34, s44
    v_perm_b32 v83, v46, v42, s44
    v_mfma_f32_16x16x32_bf16 v[60:63], v[8:11], v[92:95], 0
    v_perm_b32 v84, v22, v18, s45
    v_perm_b32 v85, v30, v26, s45
    v_perm_b32 v86, v38, v34, s45
    v_perm_b32 v87, v46, v42, s45
    v_mfma_f32_16x16x32_bf16 v[64:67], v[8:11], v[80:83], 0
    v_perm_b32 v88, v23, v19, s44
    v_perm_b32 v89, v31, v27, s44
    v_perm_b32 v90, v39, v35, s44
    v_perm_b32 v91, v47, v43, s44
    v_mfma_f32_16x16x32_bf16 v[68:71], v[8:11], v[84:87], 0
    v_perm_b32 v92, v23, v19, s45
    v_perm_b32 v93, v31, v27, s45
    v_perm_b32 v94, v39, v35, s45
    v_perm_b32 v95, v47, v43, s45
    v_mfma_f32_16x16x32_bf16 v[72:75], v[8:11], v[88:91], 0
    s_nop 1
    v_mfma_f32_16x16x32_bf16 v[76:79], v[8:11], v[92:95], 0
    s_nop 7
    s_mov_b64 exec, 0xffff
    ds_write_b128 v7, v[48:51] offset:0
    ds_write_b128 v7, v[52:55] offset:16
    ds_write_b128 v7, v[56:59] offset:32
    ds_write_b128 v7, v[60:63] offset:48
    ds_write_b128 v7, v[64:67] offset:64
    ds_write_b128 v7, v[68:71] offset:80
    ds_write_b128 v7, v[72:75] offset:96
    ds_write_b128 v7, v[76:79] offset:112
    s_mov_b64 exec, -1
    s_waitcnt lgkmcnt(0)
    s_barrier
    v_lshlrev_b32 v96, 2, v0
    ds_read_b32 v98, v96 offset:0
    ds_read_b32 v102, v96 offset:1024
    ds_read_b32 v99, v96 offset:2048
    ds_read_b32 v103, v96 offset:3072
    ds_read_b32 v100, v96 offset:4096
    ds_read_b32 v104, v96 offset:5120
    ds_read_b32 v101, v96 offset:6144
    ds_read_b32 v105, v96 offset:7168
    v_and_b32 v106, 3, v0
    v_mul_lo_u32 v106, v106, s39
    v_lshrrev_b32 v107, 5, v0
    v_lshlrev_b32 v107, 3, v107
    v_bfe_u32 v108, v0, 2, 3
    v_add3_u32 v106, v106, v107, v108
    v_lshlrev_b32 v106, 2, v106
    s_waitcnt lgkmcnt(0)
    v_add_f32 v98, v98, v99
    v_add_f32 v100, v100, v101
    v_add_f32 v102, v102, v103
    v_add_f32 v104, v104, v105
    v_add_f32 v98, v98, v100
    v_add_f32 v102, v102, v104
    buffer_store_dword v98, v106, s[20:23], s47 offen
    buffer_store_dword v102, v106, s[20:23], s47 offen offset:256
K3_END:
K3_EXIT:
    s_endpgm
.globl k4_final_kernel
.p2align 8
.type k4_final_kernel,@function
k4_final_kernel:
    s_cmp_ge_u32 s2, 8
    s_cbranch_scc1 K4_EXIT
    s_load_dwordx2 s[4:5], s[0:1], 0
    s_load_dwordx2 s[6:7], s[0:1], 72
    s_load_dwordx2 s[8:9], s[0:1], 80
    s_load_dwordx2 s[10:11], s[0:1], 96
    s_lshl_b32 s3, s2, 8
    v_add_u32 v1, s3, v0
    v_and_b32 v2, 63, v0
    s_waitcnt lgkmcnt(0)
    s_mov_b32 s12, s4
    s_and_b32 s13, s5, 0xffff
    s_mov_b32 s14, 4096
    s_mov_b32 s15, 0x00020000
    s_mov_b32 s16, s6
    s_and_b32 s17, s7, 0xffff
    s_mov_b32 s18, 1024
    s_mov_b32 s19, 0x00020000
    s_mov_b32 s20, s8
    s_and_b32 s21, s9, 0xffff
    s_mov_b32 s22, 4096
    s_mov_b32 s23, 0x00020000
    s_mov_b32 s24, s10
    s_and_b32 s25, s11, 0xffff
    s_mov_b32 s26, 1507328
    s_mov_b32 s27, 0x00020000
    v_lshlrev_b32 v3, 2, v1
    s_mov_b32 s28, 1114112
    buffer_load_dword v16, v3, s[24:27], s28 offen
    s_add_u32 s28, s28, 8192
    buffer_load_dword v17, v3, s[24:27], s28 offen
    s_add_u32 s28, s28, 8192
    buffer_load_dword v18, v3, s[24:27], s28 offen
    s_add_u32 s28, s28, 8192
    buffer_load_dword v19, v3, s[24:27], s28 offen
    s_add_u32 s28, s28, 8192
    buffer_load_dword v20, v3, s[24:27], s28 offen
    s_add_u32 s28, s28, 8192
    buffer_load_dword v21, v3, s[24:27], s28 offen
    s_add_u32 s28, s28, 8192
    buffer_load_dword v22, v3, s[24:27], s28 offen
    s_add_u32 s28, s28, 8192
    buffer_load_dword v23, v3, s[24:27], s28 offen
    s_add_u32 s28, s28, 8192
    buffer_load_dword v24, v3, s[24:27], s28 offen
    s_add_u32 s28, s28, 8192
    buffer_load_dword v25, v3, s[24:27], s28 offen
    s_add_u32 s28, s28, 8192
    buffer_load_dword v26, v3, s[24:27], s28 offen
    s_add_u32 s28, s28, 8192
    buffer_load_dword v27, v3, s[24:27], s28 offen
    s_add_u32 s28, s28, 8192
    buffer_load_dword v28, v3, s[24:27], s28 offen
    s_add_u32 s28, s28, 8192
    buffer_load_dword v29, v3, s[24:27], s28 offen
    s_add_u32 s28, s28, 8192
    buffer_load_dword v30, v3, s[24:27], s28 offen
    s_add_u32 s28, s28, 8192
    buffer_load_dword v31, v3, s[24:27], s28 offen
    s_add_u32 s28, s28, 8192
    buffer_load_dword v32, v3, s[24:27], s28 offen
    s_add_u32 s28, s28, 8192
    buffer_load_dword v33, v3, s[24:27], s28 offen
    s_add_u32 s28, s28, 8192
    buffer_load_dword v34, v3, s[24:27], s28 offen
    s_add_u32 s28, s28, 8192
    buffer_load_dword v35, v3, s[24:27], s28 offen
    s_add_u32 s28, s28, 8192
    buffer_load_dword v36, v3, s[24:27], s28 offen
    s_add_u32 s28, s28, 8192
    buffer_load_dword v37, v3, s[24:27], s28 offen
    s_add_u32 s28, s28, 8192
    buffer_load_dword v38, v3, s[24:27], s28 offen
    s_add_u32 s28, s28, 8192
    buffer_load_dword v39, v3, s[24:27], s28 offen
    s_add_u32 s28, s28, 8192
    buffer_load_dword v40, v3, s[24:27], s28 offen
    s_add_u32 s28, s28, 8192
    buffer_load_dword v41, v3, s[24:27], s28 offen
    s_add_u32 s28, s28, 8192
    buffer_load_dword v42, v3, s[24:27], s28 offen
    s_add_u32 s28, s28, 8192
    buffer_load_dword v43, v3, s[24:27], s28 offen
    s_add_u32 s28, s28, 8192
    buffer_load_dword v44, v3, s[24:27], s28 offen
    s_add_u32 s28, s28, 8192
    buffer_load_dword v45, v3, s[24:27], s28 offen
    s_add_u32 s28, s28, 8192
    buffer_load_dword v46, v3, s[24:27], s28 offen
    s_add_u32 s28, s28, 8192
    buffer_load_dword v47, v3, s[24:27], s28 offen
    s_add_u32 s28, s28, 8192
    buffer_load_dword v48, v3, s[24:27], s28 offen
    s_add_u32 s28, s28, 8192
    buffer_load_dword v49, v3, s[24:27], s28 offen
    s_add_u32 s28, s28, 8192
    buffer_load_dword v50, v3, s[24:27], s28 offen
    s_add_u32 s28, s28, 8192
    buffer_load_dword v51, v3, s[24:27], s28 offen
    s_add_u32 s28, s28, 8192
    buffer_load_dword v52, v3, s[24:27], s28 offen
    s_add_u32 s28, s28, 8192
    buffer_load_dword v53, v3, s[24:27], s28 offen
    s_add_u32 s28, s28, 8192
    buffer_load_dword v54, v3, s[24:27], s28 offen
    s_add_u32 s28, s28, 8192
    buffer_load_dword v55, v3, s[24:27], s28 offen
    s_add_u32 s28, s28, 8192
    buffer_load_dword v56, v3, s[24:27], s28 offen
    s_add_u32 s28, s28, 8192
    buffer_load_dword v57, v3, s[24:27], s28 offen
    s_add_u32 s28, s28, 8192
    buffer_load_dword v58, v3, s[24:27], s28 offen
    s_add_u32 s28, s28, 8192
    buffer_load_dword v59, v3, s[24:27], s28 offen
    s_add_u32 s28, s28, 8192
    buffer_load_dword v60, v3, s[24:27], s28 offen
    s_add_u32 s28, s28, 8192
    buffer_load_dword v61, v3, s[24:27], s28 offen
    s_lshr_b32 s29, s2, 1
    s_lshl_b32 s29, s29, 10
    v_lshlrev_b32 v4, 4, v2
    buffer_load_dwordx4 v[64:67], v4, s[12:15], s29 offen
    buffer_load_dwordx4 v[68:71], v4, s[16:19], 0 offen
    s_waitcnt vmcnt(0)
    v_mov_b32 v80, 0
    v_lshlrev_b32 v72, 16, v64
    v_and_b32 v73, 0xffff0000, v64
    v_lshlrev_b32 v74, 16, v68
    v_and_b32 v75, 0xffff0000, v68
    v_mul_f32 v72, v72, v74
    v_mul_f32 v73, v73, v75
    v_cvt_pk_bf16_f32 v72, v72, v73
    v_lshlrev_b32 v73, 16, v72
    v_and_b32 v72, 0xffff0000, v72
    v_add_f32 v80, v80, v73
    v_add_f32 v80, v80, v72
    v_lshlrev_b32 v72, 16, v65
    v_and_b32 v73, 0xffff0000, v65
    v_lshlrev_b32 v74, 16, v69
    v_and_b32 v75, 0xffff0000, v69
    v_mul_f32 v72, v72, v74
    v_mul_f32 v73, v73, v75
    v_cvt_pk_bf16_f32 v72, v72, v73
    v_lshlrev_b32 v73, 16, v72
    v_and_b32 v72, 0xffff0000, v72
    v_add_f32 v80, v80, v73
    v_add_f32 v80, v80, v72
    v_lshlrev_b32 v72, 16, v66
    v_and_b32 v73, 0xffff0000, v66
    v_lshlrev_b32 v74, 16, v70
    v_and_b32 v75, 0xffff0000, v70
    v_mul_f32 v72, v72, v74
    v_mul_f32 v73, v73, v75
    v_cvt_pk_bf16_f32 v72, v72, v73
    v_lshlrev_b32 v73, 16, v72
    v_and_b32 v72, 0xffff0000, v72
    v_add_f32 v80, v80, v73
    v_add_f32 v80, v80, v72
    v_lshlrev_b32 v72, 16, v67
    v_and_b32 v73, 0xffff0000, v67
    v_lshlrev_b32 v74, 16, v71
    v_and_b32 v75, 0xffff0000, v71
    v_mul_f32 v72, v72, v74
    v_mul_f32 v73, v73, v75
    v_cvt_pk_bf16_f32 v72, v72, v73
    v_lshlrev_b32 v73, 16, v72
    v_and_b32 v72, 0xffff0000, v72
    v_add_f32 v80, v80, v73
    v_add_f32 v80, v80, v72
    s_nop 1
    v_add_f32_dpp v80, v80, v80 quad_perm:[1,0,3,2] row_mask:0xf bank_mask:0xf
    s_nop 1
    v_add_f32_dpp v80, v80, v80 quad_perm:[2,3,0,1] row_mask:0xf bank_mask:0xf
    s_nop 1
    v_add_f32_dpp v80, v80, v80 row_half_mirror row_mask:0xf bank_mask:0xf
    s_nop 1
    v_add_f32_dpp v80, v80, v80 row_mirror row_mask:0xf bank_mask:0xf
    v_mov_b32 v81, v80
    s_nop 1
    v_permlane16_swap_b32 v80, v81
    s_nop 1
    v_add_f32 v80, v80, v81
    v_mov_b32 v81, v80
    s_nop 1
    v_permlane32_swap_b32 v80, v81
    s_nop 1
    v_add_f32 v80, v80, v81
    v_cvt_pk_bf16_f32 v81, v80, v80
    v_lshlrev_b32 v80, 16, v81
    v_mul_f32 v80, 0xbfb8aa3b, v80
    v_exp_f32 v80, v80
    s_nop 0
    v_add_f32 v80, 1.0, v80
    v_rcp_f32 v80, v80
    s_nop 0
    v_cvt_pk_bf16_f32 v81, v80, v80
    v_lshlrev_b32 v80, 16, v81
    v_add_f32 v16, v16, v17
    v_add_f32 v16, v16, v18
    v_add_f32 v16, v16, v19
    v_add_f32 v16, v16, v20
    v_add_f32 v16, v16, v21
    v_add_f32 v16, v16, v22
    v_add_f32 v16, v16, v23
    v_add_f32 v16, v16, v24
    v_add_f32 v16, v16, v25
    v_add_f32 v16, v16, v26
    v_add_f32 v16, v16, v27
    v_add_f32 v16, v16, v28
    v_add_f32 v16, v16, v29
    v_add_f32 v16, v16, v30
    v_add_f32 v16, v16, v31
    v_add_f32 v16, v16, v32
    v_add_f32 v16, v16, v33
    v_add_f32 v16, v16, v34
    v_add_f32 v16, v16, v35
    v_add_f32 v16, v16, v36
    v_add_f32 v16, v16, v37
    v_add_f32 v16, v16, v38
    v_add_f32 v16, v16, v39
    v_add_f32 v16, v16, v40
    v_add_f32 v16, v16, v41
    v_add_f32 v16, v16, v42
    v_add_f32 v16, v16, v43
    v_add_f32 v16, v16, v44
    v_add_f32 v16, v16, v45
    v_add_f32 v16, v16, v46
    v_add_f32 v16, v16, v47
    v_add_f32 v48, v48, v49
    v_add_f32 v48, v48, v50
    v_add_f32 v48, v48, v51
    v_add_f32 v48, v48, v52
    v_add_f32 v48, v48, v53
    v_add_f32 v48, v48, v54
    v_add_f32 v48, v48, v55
    v_add_f32 v48, v48, v56
    v_add_f32 v48, v48, v57
    v_add_f32 v48, v48, v58
    v_add_f32 v48, v48, v59
    v_add_f32 v48, v48, v60
    v_add_f32 v48, v48, v61
    v_cvt_pk_bf16_f32 v81, v16, v16
    v_lshlrev_b32 v16, 16, v81
    v_cvt_pk_bf16_f32 v81, v48, v48
    v_lshlrev_b32 v48, 16, v81
    v_mul_f32 v16, v80, v16
    v_cvt_pk_bf16_f32 v81, v16, v16
    v_lshlrev_b32 v16, 16, v81
    v_sub_f32 v82, 1.0, v80
    v_cvt_pk_bf16_f32 v81, v82, v82
    v_lshlrev_b32 v82, 16, v81
    v_mul_f32 v48, v82, v48
    v_cvt_pk_bf16_f32 v81, v48, v48
    v_lshlrev_b32 v48, 16, v81
    v_add_f32 v16, v16, v48
    v_cvt_pk_bf16_f32 v16, v16, v16
    v_lshlrev_b32 v3, 1, v1
    buffer_store_short v16, v3, s[20:23], 0 offen
K4_END:
K4_EXIT:
    s_endpgm
.section .rodata,"a"
.p2align 6
.amdhsa_kernel k1_proj_kernel
  .amdhsa_next_free_vgpr 112
  .amdhsa_next_free_sgpr 96
  .amdhsa_accum_offset 112
  .amdhsa_group_segment_fixed_size 0
  .amdhsa_kernarg_size 104
  .amdhsa_user_sgpr_count 2
  .amdhsa_user_sgpr_kernarg_segment_ptr 1
  .amdhsa_system_sgpr_workgroup_id_x 1
.end_amdhsa_kernel
.p2align 6
.amdhsa_kernel k2_attn_kernel
  .amdhsa_next_free_vgpr 120
  .amdhsa_next_free_sgpr 96
  .amdhsa_accum_offset 120
  .amdhsa_group_segment_fixed_size 0
  .amdhsa_kernarg_size 104
  .amdhsa_user_sgpr_count 2
  .amdhsa_user_sgpr_kernarg_segment_ptr 1
  .amdhsa_system_sgpr_workgroup_id_x 1
.end_amdhsa_kernel
.p2align 6
.amdhsa_kernel k3_oproj_kernel
  .amdhsa_next_free_vgpr 144
  .amdhsa_next_free_sgpr 96
  .amdhsa_accum_offset 144
  .amdhsa_group_segment_fixed_size 0
  .amdhsa_kernarg_size 104
  .amdhsa_user_sgpr_count 2
  .amdhsa_user_sgpr_kernarg_segment_ptr 1
  .amdhsa_system_sgpr_workgroup_id_x 1
.end_amdhsa_kernel
.p2align 6
.amdhsa_kernel k4_final_kernel
  .amdhsa_next_free_vgpr 96
  .amdhsa_next_free_sgpr 96
  .amdhsa_accum_offset 96
  .amdhsa_group_segment_fixed_size 0
  .amdhsa_kernarg_size 104
  .amdhsa_user_sgpr_count 2
  .amdhsa_user_sgpr_kernarg_segment_ptr 1
  .amdhsa_system_sgpr_workgroup_id_x 1
.end_amdhsa_kernel
```
